```python
import torch

def _softmax(x, axis=-1):
    return torch.softmax(x, dim=axis)
def _gelu(x):
    return torch.nn.functional.gelu(x, approximate="tanh")
def _silu(x):
    return torch.nn.functional.silu(x)
def _sigmoid(x):
    return torch.sigmoid(x)
def _layernorm(x, axis=-1, eps=1e-5):
    m = x.mean(dim=axis, keepdim=True)
    v = x.var(dim=axis, keepdim=True, unbiased=False)
    return (x - m) / torch.sqrt(v + eps)
def _scatter_add(tgt, idx, src, axis=0):
    return tgt.clone().index_add_(axis, idx, src)
def _segment_sum(src, seg, n):
    out = torch.zeros((n,) + src.shape[1:], dtype=src.dtype)
    return out.index_add_(0, seg, src)
def _pad(x, pw):
    flat = tuple(v for pair in reversed(pw) for v in pair)
    return torch.nn.functional.pad(x, flat)

kernel_name = 'standalone__paged_block_table_kv_pagedattention__decode'

def setup_inputs():

    _w = (lambda a: (lambda t: t.to(torch.bfloat16) if t.is_floating_point() else t)(torch.as_tensor(a)))
    B, Hq, Hkv, Sq, Skv, D = 1, 32, 32, 1, 4096, 128
    bs = 16
    nbps = max(1, Skv // bs)
    num_phys = B * nbps + 4
    bt = torch.randperm(num_phys)[: B * nbps].reshape(B, nbps).to(torch.int64)
    cl = (nbps * bs - (torch.arange(1, B + 1, dtype=torch.int64) * 2654435761) % max(1, nbps * bs // 2)).to(torch.int64)
    return {
        "q": _w((lambda *s: torch.randn(*s, dtype=torch.bfloat16) * 0.8)(B, Hq, Sq, D)),
        "k_cache": _w((lambda *s: torch.randn(*s, dtype=torch.bfloat16) * 0.8)(num_phys, bs, Hkv, D)),
        "v_cache": _w((lambda *s: torch.randn(*s, dtype=torch.bfloat16) * 0.05)(num_phys, bs, Hkv, D)),
        "block_table": _w(bt),
        "context_lens": _w(cl),
    }

def reference(q, k_cache, v_cache, block_table, context_lens):
    B, Hq, Sq, D = q.shape
    bs = k_cache.shape[1]
    Hkv = k_cache.shape[2]
    nbps = block_table.shape[1]
    Skv = nbps * bs
    bt = block_table.reshape(-1)
    k = (lambda x, *d: x.permute(*d))(k_cache[bt].reshape(B, Skv, Hkv, D), 0, 2, 1, 3)
    v = (lambda x, *d: x.permute(*d))(v_cache[bt].reshape(B, Skv, Hkv, D), 0, 2, 1, 3)
    g = Hq // Hkv
    qg = q.reshape(B, Hkv, g, Sq, D)
    scores = torch.einsum("bhgqd,bhkd->bhgqk", qg, k) * (D ** -0.5)
    pos = torch.arange(Skv)
    msk = pos[None, :] < context_lens[:, None]
    scores = torch.where(msk[:, None, None, None, :], scores, -1e9)
    p = _softmax(scores, axis=-1)
    out = torch.einsum("bhgqk,bhkd->bhgqd", p, v)
    return out.reshape(B, Hq, Sq, D)
```

```asm
; @launch grid=(256,1,1) block=(512,1,1) lds=8448
.amdgcn_target "amdgcn-amd-amdhsa--gfx950"
.text
.globl standalone__paged_block_table_kv_pagedattention__decode_kernel
.p2align 8
.type standalone__paged_block_table_kv_pagedattention__decode_kernel,@function
standalone__paged_block_table_kv_pagedattention__decode_kernel:
  s_cmp_ge_u32 s2, 256
  s_cbranch_scc1 L_end
  s_load_dwordx16 s[4:19], s[0:1], 0
  s_getpc_b64 s[46:47]
L_pc:
  v_lshlrev_b32 v7, 4, v0
  v_min_u32 v7, L_codeend-L_pc-16, v7
  global_load_dwordx4 v[164:167], v7, s[46:47]
  v_lshrrev_b32 v7, 6, v0
  v_and_b32 v2, 15, v0
  v_readfirstlane_b32 s30, v7
  v_bfe_u32 v3, v0, 4, 2
  v_and_b32 v1, 63, v0
  s_mov_b32 s28, 0x76543210
  s_mov_b32 s29, 0x9edcbaf8
  s_and_b32 s36, s2, 15
  s_lshl_b32 s36, s36, 2
  s_lshr_b64 s[28:29], s[28:29], s36
  s_and_b32 s28, s28, 15
  s_lshr_b32 s29, s2, 4
  s_lshl_b32 s31, s28, 4
  s_add_u32 s31, s31, s29
  s_getreg_b32 s38, hwreg(HW_REG_XCC_ID)
  s_and_b32 s38, s38, 15
  s_lshr_b32 s36, s29, 3
  s_lshl_b32 s37, s30, 1
  s_add_u32 s39, s36, s37
  s_lshl_b32 s36, s39, 2
  v_lshlrev_b32 v18, 6, v2
  v_add_u32 v18, s36, v18
  s_lshl_b32 s36, s28, 9
  v_and_b32 v19, 31, v0
  v_lshlrev_b32 v19, 4, v19
  v_add_u32 v19, s36, v19
  s_and_b32 s36, s29, 7
  s_lshl_b32 s36, s36, 1
  v_lshrrev_b32 v7, 1, v3
  v_add_u32 v7, s36, v7
  v_lshlrev_b32 v5, 13, v7
  v_add_u32 v5, v5, v19
  s_lshl_b32 s36, s39, 4
  v_lshl_add_u32 v4, v2, 8, v7
  v_add_u32 v4, s36, v4
  s_lshl_b32 s36, s31, 10
  v_lshlrev_b32 v38, 4, v1
  v_add_u32 v34, s36, v38
  v_add_u32 v33, 524288, v34
  s_lshl_b32 s37, s31, 5
  s_add_u32 s37, s37, 262144
  v_and_b32 v16, 1, v3
  v_lshl_add_u32 v35, v16, 4, s37
  s_lshl_b32 s36, s39, 17
  v_add_u32 v31, s36, v5
  v_mov_b32 v20, -1
  v_mov_b32 v21, -1
  v_mov_b32 v22, -1
  v_mov_b32 v23, -1
  s_waitcnt lgkmcnt(0)
  s_load_dword s32, s[12:13], 0
  global_load_dword v6, v18, s[10:11]
  global_load_dwordx4 v[104:107], v31, s[6:7]
  v_add_u32 v31, 2097152, v31
  global_load_dwordx4 v[108:111], v31, s[6:7]
  global_load_dwordx4 v[8:11], v19, s[4:5]
  s_cmp_lg_u32 s30, 7
  s_cbranch_scc1 L_noclear
  global_store_dwordx4 v34, v[20:23], s[18:19] sc1
  global_store_dwordx4 v35, v[20:23], s[18:19] sc1
  global_store_dwordx4 v33, v[20:23], s[18:19]
L_noclear:
  s_mov_b32 s20, s6
  s_and_b32 s21, s7, 0xffff
  s_mov_b32 s22, 34078720
  s_mov_b32 s23, 0x00020000
  s_mov_b32 s24, s8
  s_and_b32 s25, s9, 0xffff
  s_mov_b32 s26, 34078720
  s_mov_b32 s27, 0x00020000
  s_mov_b32 s35, 0x3e0293ee
  v_and_b32 v7, 1, v2
  v_mov_b32 v37, 0xffff
  v_lshlrev_b32 v39, 4, v7
  v_lshlrev_b32 v37, v39, v37
  v_cmp_eq_u32_e64 s[42:43], 1, v7
  v_lshrrev_b32 v7, 3, v2
  v_cmp_eq_u32 vcc, v7, v16
  v_and_b32 v7, 2, v2
  v_cmp_eq_u32_e64 s[40:41], 2, v7
  v_cndmask_b32 v37, 0, v37, vcc
  v_lshlrev_b32 v16, 6, v16
  v_lshrrev_b32 v7, 5, v0
  v_cndmask_b32_e64 v12, v37, 0, s[40:41]
  v_cndmask_b32_e64 v13, 0, v37, s[40:41]
  v_lshl_add_u32 v39, v7, 2, v16
  s_lshl_b32 s36, s30, 10
  v_add_u32 v37, s36, v38
  s_lshl_b32 s36, s28, 4
  v_mov_b32 v36, s36
  v_mov_b32 v7, 1
  s_waitcnt vmcnt(3) lgkmcnt(0)
  s_cmp_lg_u32 s30, 7
  s_cbranch_scc1 L_noflag
  s_waitcnt vmcnt(0)
  s_mov_b64 exec, 1
  global_atomic_add v36, v7, s[16:17] sc1
  s_mov_b64 exec, -1
L_noflag:
  s_cmp_lt_i32 s32, 1
  s_cselect_b32 s33, 4096, s32
  s_cselect_b32 s34, 0, 0xf149f2ca
  s_min_u32 s33, s33, 4096
  v_lshlrev_b32 v6, 17, v6
  v_cmp_gt_u32 vcc, s33, v4
  v_cmp_gt_i32_e64 s[44:45], s32, v4
  v_mov_b32 v17, s34
  v_cndmask_b32 v6, 0x40000000, v6, vcc
  s_nop 1
  v_add_u32_dpp v31, v6, v5 row_newbcast:0 row_mask:0xf bank_mask:0xf
  buffer_load_dwordx4 v[40:43], v31, s[20:23], 0 offen nt
  v_add_u32_dpp v32, v6, v5 row_newbcast:8 row_mask:0xf bank_mask:0xf
  buffer_load_dwordx4 v[44:47], v32, s[20:23], 0 offen nt
  v_add_u32_dpp v31, v6, v5 row_newbcast:4 row_mask:0xf bank_mask:0xf
  buffer_load_dwordx4 v[48:51], v31, s[20:23], 0 offen nt
  v_add_u32_dpp v32, v6, v5 row_newbcast:12 row_mask:0xf bank_mask:0xf
  buffer_load_dwordx4 v[52:55], v32, s[20:23], 0 offen nt
  v_add_u32_dpp v31, v6, v5 row_newbcast:2 row_mask:0xf bank_mask:0xf
  buffer_load_dwordx4 v[56:59], v31, s[20:23], 0 offen nt
  v_add_u32_dpp v32, v6, v5 row_newbcast:10 row_mask:0xf bank_mask:0xf
  buffer_load_dwordx4 v[60:63], v32, s[20:23], 0 offen nt
  v_add_u32_dpp v31, v6, v5 row_newbcast:6 row_mask:0xf bank_mask:0xf
  buffer_load_dwordx4 v[64:67], v31, s[20:23], 0 offen nt
  v_add_u32_dpp v32, v6, v5 row_newbcast:14 row_mask:0xf bank_mask:0xf
  buffer_load_dwordx4 v[68:71], v32, s[20:23], 0 offen nt
  v_add_u32_dpp v31, v6, v5 row_newbcast:1 row_mask:0xf bank_mask:0xf
  buffer_load_dwordx4 v[72:75], v31, s[20:23], 0 offen nt
  v_add_u32_dpp v32, v6, v5 row_newbcast:9 row_mask:0xf bank_mask:0xf
  buffer_load_dwordx4 v[76:79], v32, s[20:23], 0 offen nt
  v_add_u32_dpp v31, v6, v5 row_newbcast:5 row_mask:0xf bank_mask:0xf
  buffer_load_dwordx4 v[80:83], v31, s[20:23], 0 offen nt
  v_add_u32_dpp v32, v6, v5 row_newbcast:13 row_mask:0xf bank_mask:0xf
  buffer_load_dwordx4 v[84:87], v32, s[20:23], 0 offen nt
  v_add_u32_dpp v31, v6, v5 row_newbcast:3 row_mask:0xf bank_mask:0xf
  buffer_load_dwordx4 v[88:91], v31, s[20:23], 0 offen nt
  v_add_u32_dpp v32, v6, v5 row_newbcast:11 row_mask:0xf bank_mask:0xf
  buffer_load_dwordx4 v[92:95], v32, s[20:23], 0 offen nt
  v_add_u32_dpp v31, v6, v5 row_newbcast:7 row_mask:0xf bank_mask:0xf
  buffer_load_dwordx4 v[96:99], v31, s[20:23], 0 offen nt
  v_add_u32_dpp v32, v6, v5 row_newbcast:15 row_mask:0xf bank_mask:0xf
  buffer_load_dwordx4 v[100:103], v32, s[20:23], 0 offen nt
  s_barrier
  v_add_u32_dpp v31, v6, v5 row_newbcast:0 row_mask:0xf bank_mask:0xf
  buffer_load_dwordx4 v[104:107], v31, s[24:27], 0 offen nt
  v_add_u32_dpp v32, v6, v5 row_newbcast:8 row_mask:0xf bank_mask:0xf
  buffer_load_dwordx4 v[108:111], v32, s[24:27], 0 offen nt
  v_add_u32_dpp v31, v6, v5 row_newbcast:4 row_mask:0xf bank_mask:0xf
  buffer_load_dwordx4 v[112:115], v31, s[24:27], 0 offen nt
  v_add_u32_dpp v32, v6, v5 row_newbcast:12 row_mask:0xf bank_mask:0xf
  buffer_load_dwordx4 v[116:119], v32, s[24:27], 0 offen nt
  s_waitcnt vmcnt(16)
  v_dot2_f32_bf16 v20, v40, v8, 0
  v_dot2_f32_bf16 v21, v44, v8, 0
  v_dot2_f32_bf16 v22, v48, v8, 0
  v_dot2_f32_bf16 v23, v52, v8, 0
  v_dot2_f32_bf16 v20, v41, v9, v20
  v_dot2_f32_bf16 v21, v45, v9, v21
  v_dot2_f32_bf16 v22, v49, v9, v22
  v_dot2_f32_bf16 v23, v53, v9, v23
  v_dot2_f32_bf16 v20, v42, v10, v20
  v_dot2_f32_bf16 v21, v46, v10, v21
  v_dot2_f32_bf16 v22, v50, v10, v22
  v_dot2_f32_bf16 v23, v54, v10, v23
  v_dot2_f32_bf16 v20, v43, v11, v20
  v_dot2_f32_bf16 v21, v47, v11, v21
  v_dot2_f32_bf16 v22, v51, v11, v22
  v_dot2_f32_bf16 v23, v55, v11, v23
  v_add_f32_dpp v24, v20, v20 row_ror:8 row_mask:0xf bank_mask:0x3
  v_add_f32_dpp v24, v21, v21 row_ror:8 row_mask:0xf bank_mask:0xc
  v_add_f32_dpp v25, v22, v22 row_ror:8 row_mask:0xf bank_mask:0x3
  v_add_f32_dpp v25, v23, v23 row_ror:8 row_mask:0xf bank_mask:0xc
  v_add_f32_dpp v26, v24, v24 row_ror:12 row_mask:0xf bank_mask:0x5
  s_nop 0
  v_add_f32_dpp v26, v25, v25 row_ror:4 row_mask:0xf bank_mask:0xa
  s_waitcnt vmcnt(12)
  v_dot2_f32_bf16 v20, v56, v8, 0
  v_dot2_f32_bf16 v21, v60, v8, 0
  v_dot2_f32_bf16 v22, v64, v8, 0
  v_dot2_f32_bf16 v23, v68, v8, 0
  v_dot2_f32_bf16 v20, v57, v9, v20
  v_dot2_f32_bf16 v21, v61, v9, v21
  v_dot2_f32_bf16 v22, v65, v9, v22
  v_dot2_f32_bf16 v23, v69, v9, v23
  v_dot2_f32_bf16 v20, v58, v10, v20
  v_dot2_f32_bf16 v21, v62, v10, v21
  v_dot2_f32_bf16 v22, v66, v10, v22
  v_dot2_f32_bf16 v23, v70, v10, v23
  v_dot2_f32_bf16 v20, v59, v11, v20
  v_dot2_f32_bf16 v21, v63, v11, v21
  v_dot2_f32_bf16 v22, v67, v11, v22
  v_dot2_f32_bf16 v23, v71, v11, v23
  v_add_f32_dpp v24, v20, v20 row_ror:8 row_mask:0xf bank_mask:0x3
  v_add_f32_dpp v24, v21, v21 row_ror:8 row_mask:0xf bank_mask:0xc
  v_add_f32_dpp v25, v22, v22 row_ror:8 row_mask:0xf bank_mask:0x3
  v_add_f32_dpp v25, v23, v23 row_ror:8 row_mask:0xf bank_mask:0xc
  v_add_f32_dpp v27, v24, v24 row_ror:12 row_mask:0xf bank_mask:0x5
  s_nop 0
  v_add_f32_dpp v27, v25, v25 row_ror:4 row_mask:0xf bank_mask:0xa
  v_cndmask_b32_e64 v30, v27, v26, s[40:41]
  v_cndmask_b32_e64 v26, v26, v27, s[40:41]
  s_nop 0
  v_add_f32_dpp v26, v30, v26 quad_perm:[2,3,0,1] row_mask:0xf bank_mask:0xf
  s_waitcnt vmcnt(8)
  v_dot2_f32_bf16 v20, v72, v8, 0
  v_dot2_f32_bf16 v21, v76, v8, 0
  v_dot2_f32_bf16 v22, v80, v8, 0
  v_dot2_f32_bf16 v23, v84, v8, 0
  v_dot2_f32_bf16 v20, v73, v9, v20
  v_dot2_f32_bf16 v21, v77, v9, v21
  v_dot2_f32_bf16 v22, v81, v9, v22
  v_dot2_f32_bf16 v23, v85, v9, v23
  v_dot2_f32_bf16 v20, v74, v10, v20
  v_dot2_f32_bf16 v21, v78, v10, v21
  v_dot2_f32_bf16 v22, v82, v10, v22
  v_dot2_f32_bf16 v23, v86, v10, v23
  v_dot2_f32_bf16 v20, v75, v11, v20
  v_dot2_f32_bf16 v21, v79, v11, v21
  v_dot2_f32_bf16 v22, v83, v11, v22
  v_dot2_f32_bf16 v23, v87, v11, v23
  v_add_f32_dpp v24, v20, v20 row_ror:8 row_mask:0xf bank_mask:0x3
  v_add_f32_dpp v24, v21, v21 row_ror:8 row_mask:0xf bank_mask:0xc
  v_add_f32_dpp v25, v22, v22 row_ror:8 row_mask:0xf bank_mask:0x3
  v_add_f32_dpp v25, v23, v23 row_ror:8 row_mask:0xf bank_mask:0xc
  v_add_f32_dpp v28, v24, v24 row_ror:12 row_mask:0xf bank_mask:0x5
  s_nop 0
  v_add_f32_dpp v28, v25, v25 row_ror:4 row_mask:0xf bank_mask:0xa
  s_waitcnt vmcnt(4)
  v_dot2_f32_bf16 v20, v88, v8, 0
  v_dot2_f32_bf16 v21, v92, v8, 0
  v_dot2_f32_bf16 v22, v96, v8, 0
  v_dot2_f32_bf16 v23, v100, v8, 0
  v_dot2_f32_bf16 v20, v89, v9, v20
  v_dot2_f32_bf16 v21, v93, v9, v21
  v_dot2_f32_bf16 v22, v97, v9, v22
  v_dot2_f32_bf16 v23, v101, v9, v23
  v_dot2_f32_bf16 v20, v90, v10, v20
  v_dot2_f32_bf16 v21, v94, v10, v21
  v_dot2_f32_bf16 v22, v98, v10, v22
  v_dot2_f32_bf16 v23, v102, v10, v23
  v_dot2_f32_bf16 v20, v91, v11, v20
  v_dot2_f32_bf16 v21, v95, v11, v21
  v_dot2_f32_bf16 v22, v99, v11, v22
  v_dot2_f32_bf16 v23, v103, v11, v23
  v_add_f32_dpp v24, v20, v20 row_ror:8 row_mask:0xf bank_mask:0x3
  v_add_f32_dpp v24, v21, v21 row_ror:8 row_mask:0xf bank_mask:0xc
  v_add_f32_dpp v25, v22, v22 row_ror:8 row_mask:0xf bank_mask:0x3
  v_add_f32_dpp v25, v23, v23 row_ror:8 row_mask:0xf bank_mask:0xc
  v_add_f32_dpp v29, v24, v24 row_ror:12 row_mask:0xf bank_mask:0x5
  s_nop 0
  v_add_f32_dpp v29, v25, v25 row_ror:4 row_mask:0xf bank_mask:0xa
  v_cndmask_b32_e64 v30, v29, v28, s[40:41]
  v_cndmask_b32_e64 v28, v28, v29, s[40:41]
  s_nop 0
  v_add_f32_dpp v28, v30, v28 quad_perm:[2,3,0,1] row_mask:0xf bank_mask:0xf
  v_cndmask_b32_e64 v30, v28, v26, s[42:43]
  v_cndmask_b32_e64 v26, v26, v28, s[42:43]
  s_nop 0
  v_add_f32_dpp v26, v30, v26 quad_perm:[1,0,3,2] row_mask:0xf bank_mask:0xf
  v_mul_f32 v26, s35, v26
  v_cndmask_b32_e64 v26, v17, v26, s[44:45]
  s_nop 1
  v_max_f32_dpp v7, v26, v26 row_ror:8 row_mask:0xf bank_mask:0xf
  s_nop 1
  v_max_f32_dpp v7, v7, v7 row_ror:4 row_mask:0xf bank_mask:0xf
  s_nop 1
  v_max_f32_dpp v7, v7, v7 row_ror:2 row_mask:0xf bank_mask:0xf
  s_nop 1
  v_max_f32_dpp v7, v7, v7 row_ror:1 row_mask:0xf bank_mask:0xf
  ds_write_b32 v39, v7 offset:8192
  s_waitcnt lgkmcnt(0)
  s_barrier
  ds_read_b128 v[40:43], v16 offset:8192
  ds_read_b128 v[44:47], v16 offset:8208
  ds_read_b128 v[48:51], v16 offset:8224
  ds_read_b128 v[52:55], v16 offset:8240
  s_waitcnt lgkmcnt(3)
  v_max3_f32 v7, v7, v40, v41
  v_max3_f32 v7, v7, v42, v43
  s_waitcnt lgkmcnt(2)
  v_max3_f32 v7, v7, v44, v45
  v_max3_f32 v7, v7, v46, v47
  s_waitcnt lgkmcnt(1)
  v_max3_f32 v7, v7, v48, v49
  v_max3_f32 v7, v7, v50, v51
  s_waitcnt lgkmcnt(0)
  v_max3_f32 v7, v7, v52, v53
  v_max3_f32 v7, v7, v54, v55
  v_sub_f32 v26, v26, v7
  v_exp_f32 v26, v26
  s_nop 0
  v_cvt_pk_bf16_f32 v14, v26, v26
  v_add_f32_dpp v19, v26, v26 row_ror:8 row_mask:0xf bank_mask:0xf
  v_and_b32 v15, 0xffff0000, v14
  v_sub_f32 v15, v26, v15
  v_add_f32_dpp v19, v19, v19 row_ror:4 row_mask:0xf bank_mask:0xf
  v_cvt_pk_bf16_f32 v15, v15, v15
  s_nop 0
  v_add_f32_dpp v19, v19, v19 row_ror:2 row_mask:0xf bank_mask:0xf
  s_nop 1
  v_add_f32_dpp v19, v19, v19 row_ror:1 row_mask:0xf bank_mask:0xf
  ds_write_b32 v39, v19 offset:8320
  s_waitcnt lgkmcnt(0)
  s_barrier
  s_cmp_lg_u32 s30, 0
  s_cbranch_scc1 L_noml
  ds_read_b128 v[40:43], v16 offset:8320
  ds_read_b128 v[44:47], v16 offset:8336
  ds_read_b128 v[48:51], v16 offset:8352
  ds_read_b128 v[52:55], v16 offset:8368
  s_waitcnt lgkmcnt(0)
  v_pk_add_f32 v[40:41], v[40:41], v[42:43]
  v_pk_add_f32 v[44:45], v[44:45], v[46:47]
  v_pk_add_f32 v[48:49], v[48:49], v[50:51]
  v_pk_add_f32 v[52:53], v[52:53], v[54:55]
  v_pk_add_f32 v[40:41], v[40:41], v[44:45]
  v_pk_add_f32 v[48:49], v[48:49], v[52:53]
  v_pk_add_f32 v[40:41], v[40:41], v[48:49]
  v_add_f32 v9, v40, v41
  v_min_u32 v8, -2, v7
  v_min_u32 v9, -2, v9
  v_mov_b32 v10, s38
  global_store_dwordx3 v35, v[8:10], s[18:19] sc1
L_noml:
  v_add_u32_dpp v31, v6, v5 row_newbcast:2 row_mask:0xf bank_mask:0xf
  buffer_load_dwordx4 v[120:123], v31, s[24:27], 0 offen nt
  v_add_u32_dpp v32, v6, v5 row_newbcast:10 row_mask:0xf bank_mask:0xf
  buffer_load_dwordx4 v[124:127], v32, s[24:27], 0 offen nt
  v_add_u32_dpp v31, v6, v5 row_newbcast:6 row_mask:0xf bank_mask:0xf
  buffer_load_dwordx4 v[128:131], v31, s[24:27], 0 offen nt
  v_add_u32_dpp v32, v6, v5 row_newbcast:14 row_mask:0xf bank_mask:0xf
  buffer_load_dwordx4 v[132:135], v32, s[24:27], 0 offen nt
  v_add_u32_dpp v31, v6, v5 row_newbcast:1 row_mask:0xf bank_mask:0xf
  buffer_load_dwordx4 v[136:139], v31, s[24:27], 0 offen nt
  v_add_u32_dpp v32, v6, v5 row_newbcast:9 row_mask:0xf bank_mask:0xf
  buffer_load_dwordx4 v[140:143], v32, s[24:27], 0 offen nt
  v_add_u32_dpp v31, v6, v5 row_newbcast:5 row_mask:0xf bank_mask:0xf
  buffer_load_dwordx4 v[144:147], v31, s[24:27], 0 offen nt
  v_add_u32_dpp v32, v6, v5 row_newbcast:13 row_mask:0xf bank_mask:0xf
  buffer_load_dwordx4 v[148:151], v32, s[24:27], 0 offen nt
  s_cmp_lg_u32 s30, 1
  s_cbranch_scc1 L_nocnt
  global_load_dword v18, v36, s[16:17] sc1
L_nocnt:
  v_add_u32_dpp v31, v6, v5 row_newbcast:3 row_mask:0xf bank_mask:0xf
  buffer_load_dwordx4 v[152:155], v31, s[24:27], 0 offen nt
  v_add_u32_dpp v32, v6, v5 row_newbcast:11 row_mask:0xf bank_mask:0xf
  buffer_load_dwordx4 v[156:159], v32, s[24:27], 0 offen nt
  v_add_u32_dpp v31, v6, v5 row_newbcast:7 row_mask:0xf bank_mask:0xf
  buffer_load_dwordx4 v[160:163], v31, s[24:27], 0 offen nt
  v_add_u32_dpp v32, v6, v5 row_newbcast:15 row_mask:0xf bank_mask:0xf
  buffer_load_dwordx4 v[164:167], v32, s[24:27], 0 offen nt
  s_cmp_gt_u32 s30, 1
  s_cbranch_scc1 L_pv
  s_cmp_eq_u32 s30, 1
  s_cbranch_scc1 L_w1
  s_lshl_b32 s36, s31, 10
  v_lshrrev_b32 v7, 1, v3
  v_lshlrev_b32 v34, 9, v7
  v_lshl_add_u32 v34, v2, 5, v34
  v_and_b32 v7, 1, v3
  v_lshl_add_u32 v34, v7, 4, v34
  v_add_u32 v34, s36, v34
  v_add_u32 v33, 524288, v34
  s_branch L_pv
L_w1:
  s_lshl_b32 s36, s28, 14
  s_lshl_b32 s37, s29, 6
  s_add_u32 s36, s36, s37
  v_lshlrev_b32 v34, 12, v3
  v_lshl_add_u32 v34, v2, 2, v34
  v_add_u32 v34, s36, v34
  s_lshl_b32 s36, s28, 9
  s_lshr_b32 s37, s29, 3
  s_lshl_b32 s37, s37, 4
  s_add_u32 s36, s36, s37
  s_add_u32 s36, s36, 262144
  v_and_b32 v7, 3, v2
  v_lshl_add_u32 v7, v3, 2, v7
  v_lshlrev_b32 v35, 5, v7
  v_add_u32 v35, s36, v35
  v_and_b32_dpp v40, v14, v12 row_newbcast:0 row_mask:0xf bank_mask:0x5
  v_and_b32_dpp v40, v15, v12 row_newbcast:0 row_mask:0xf bank_mask:0xa
  v_and_b32_dpp v41, v14, v13 row_newbcast:0 row_mask:0xf bank_mask:0x5
  v_and_b32_dpp v41, v15, v13 row_newbcast:0 row_mask:0xf bank_mask:0xa
  s_waitcnt vmcnt(16)
  s_nop 0
  v_mfma_f32_16x16x16_bf16 v[20:23], v[40:41], v[104:105], 0
  v_mfma_f32_16x16x16_bf16 v[24:27], v[40:41], v[106:107], 0
  v_and_b32_dpp v42, v14, v12 row_newbcast:8 row_mask:0xf bank_mask:0x5
  v_and_b32_dpp v42, v15, v12 row_newbcast:8 row_mask:0xf bank_mask:0xa
  v_and_b32_dpp v43, v14, v13 row_newbcast:8 row_mask:0xf bank_mask:0x5
  v_and_b32_dpp v43, v15, v13 row_newbcast:8 row_mask:0xf bank_mask:0xa
  s_waitcnt vmcnt(15)
  s_nop 0
  v_mfma_f32_16x16x16_bf16 v[20:23], v[42:43], v[108:109], v[20:23]
  v_mfma_f32_16x16x16_bf16 v[24:27], v[42:43], v[110:111], v[24:27]
  v_and_b32_dpp v44, v14, v12 row_newbcast:4 row_mask:0xf bank_mask:0x5
  v_and_b32_dpp v44, v15, v12 row_newbcast:4 row_mask:0xf bank_mask:0xa
  v_and_b32_dpp v45, v14, v13 row_newbcast:4 row_mask:0xf bank_mask:0x5
  v_and_b32_dpp v45, v15, v13 row_newbcast:4 row_mask:0xf bank_mask:0xa
  s_waitcnt vmcnt(14)
  s_nop 0
  v_mfma_f32_16x16x16_bf16 v[20:23], v[44:45], v[112:113], v[20:23]
  v_mfma_f32_16x16x16_bf16 v[24:27], v[44:45], v[114:115], v[24:27]
  v_and_b32_dpp v46, v14, v12 row_newbcast:12 row_mask:0xf bank_mask:0x5
  v_and_b32_dpp v46, v15, v12 row_newbcast:12 row_mask:0xf bank_mask:0xa
  v_and_b32_dpp v47, v14, v13 row_newbcast:12 row_mask:0xf bank_mask:0x5
  v_and_b32_dpp v47, v15, v13 row_newbcast:12 row_mask:0xf bank_mask:0xa
  s_waitcnt vmcnt(13)
  s_nop 0
  v_mfma_f32_16x16x16_bf16 v[20:23], v[46:47], v[116:117], v[20:23]
  v_mfma_f32_16x16x16_bf16 v[24:27], v[46:47], v[118:119], v[24:27]
  v_and_b32_dpp v40, v14, v12 row_newbcast:2 row_mask:0xf bank_mask:0x5
  v_and_b32_dpp v40, v15, v12 row_newbcast:2 row_mask:0xf bank_mask:0xa
  v_and_b32_dpp v41, v14, v13 row_newbcast:2 row_mask:0xf bank_mask:0x5
  v_and_b32_dpp v41, v15, v13 row_newbcast:2 row_mask:0xf bank_mask:0xa
  s_waitcnt vmcnt(12)
  s_nop 0
  v_mfma_f32_16x16x16_bf16 v[20:23], v[40:41], v[120:121], v[20:23]
  v_mfma_f32_16x16x16_bf16 v[24:27], v[40:41], v[122:123], v[24:27]
  v_and_b32_dpp v42, v14, v12 row_newbcast:10 row_mask:0xf bank_mask:0x5
  v_and_b32_dpp v42, v15, v12 row_newbcast:10 row_mask:0xf bank_mask:0xa
  v_and_b32_dpp v43, v14, v13 row_newbcast:10 row_mask:0xf bank_mask:0x5
  v_and_b32_dpp v43, v15, v13 row_newbcast:10 row_mask:0xf bank_mask:0xa
  s_waitcnt vmcnt(11)
  s_nop 0
  v_mfma_f32_16x16x16_bf16 v[20:23], v[42:43], v[124:125], v[20:23]
  v_mfma_f32_16x16x16_bf16 v[24:27], v[42:43], v[126:127], v[24:27]
  v_and_b32_dpp v44, v14, v12 row_newbcast:6 row_mask:0xf bank_mask:0x5
  v_and_b32_dpp v44, v15, v12 row_newbcast:6 row_mask:0xf bank_mask:0xa
  v_and_b32_dpp v45, v14, v13 row_newbcast:6 row_mask:0xf bank_mask:0x5
  v_and_b32_dpp v45, v15, v13 row_newbcast:6 row_mask:0xf bank_mask:0xa
  s_waitcnt vmcnt(10)
  s_nop 0
  v_mfma_f32_16x16x16_bf16 v[20:23], v[44:45], v[128:129], v[20:23]
  v_mfma_f32_16x16x16_bf16 v[24:27], v[44:45], v[130:131], v[24:27]
  v_and_b32_dpp v46, v14, v12 row_newbcast:14 row_mask:0xf bank_mask:0x5
  v_and_b32_dpp v46, v15, v12 row_newbcast:14 row_mask:0xf bank_mask:0xa
  v_and_b32_dpp v47, v14, v13 row_newbcast:14 row_mask:0xf bank_mask:0x5
  v_and_b32_dpp v47, v15, v13 row_newbcast:14 row_mask:0xf bank_mask:0xa
  s_waitcnt vmcnt(9)
  s_nop 0
  v_mfma_f32_16x16x16_bf16 v[20:23], v[46:47], v[132:133], v[20:23]
  v_mfma_f32_16x16x16_bf16 v[24:27], v[46:47], v[134:135], v[24:27]
  v_and_b32_dpp v40, v14, v12 row_newbcast:1 row_mask:0xf bank_mask:0x5
  v_and_b32_dpp v40, v15, v12 row_newbcast:1 row_mask:0xf bank_mask:0xa
  v_and_b32_dpp v41, v14, v13 row_newbcast:1 row_mask:0xf bank_mask:0x5
  v_and_b32_dpp v41, v15, v13 row_newbcast:1 row_mask:0xf bank_mask:0xa
  s_waitcnt vmcnt(8)
  s_nop 0
  v_mfma_f32_16x16x16_bf16 v[20:23], v[40:41], v[136:137], v[20:23]
  v_mfma_f32_16x16x16_bf16 v[24:27], v[40:41], v[138:139], v[24:27]
  v_and_b32_dpp v42, v14, v12 row_newbcast:9 row_mask:0xf bank_mask:0x5
  v_and_b32_dpp v42, v15, v12 row_newbcast:9 row_mask:0xf bank_mask:0xa
  v_and_b32_dpp v43, v14, v13 row_newbcast:9 row_mask:0xf bank_mask:0x5
  v_and_b32_dpp v43, v15, v13 row_newbcast:9 row_mask:0xf bank_mask:0xa
  s_waitcnt vmcnt(7)
  s_nop 0
  v_mfma_f32_16x16x16_bf16 v[20:23], v[42:43], v[140:141], v[20:23]
  v_mfma_f32_16x16x16_bf16 v[24:27], v[42:43], v[142:143], v[24:27]
  v_and_b32_dpp v44, v14, v12 row_newbcast:5 row_mask:0xf bank_mask:0x5
  v_and_b32_dpp v44, v15, v12 row_newbcast:5 row_mask:0xf bank_mask:0xa
  v_and_b32_dpp v45, v14, v13 row_newbcast:5 row_mask:0xf bank_mask:0x5
  v_and_b32_dpp v45, v15, v13 row_newbcast:5 row_mask:0xf bank_mask:0xa
  s_waitcnt vmcnt(6)
  s_nop 0
  v_mfma_f32_16x16x16_bf16 v[20:23], v[44:45], v[144:145], v[20:23]
  v_mfma_f32_16x16x16_bf16 v[24:27], v[44:45], v[146:147], v[24:27]
  v_and_b32_dpp v46, v14, v12 row_newbcast:13 row_mask:0xf bank_mask:0x5
  v_and_b32_dpp v46, v15, v12 row_newbcast:13 row_mask:0xf bank_mask:0xa
  v_and_b32_dpp v47, v14, v13 row_newbcast:13 row_mask:0xf bank_mask:0x5
  v_and_b32_dpp v47, v15, v13 row_newbcast:13 row_mask:0xf bank_mask:0xa
  s_waitcnt vmcnt(5)
  s_nop 0
  v_mfma_f32_16x16x16_bf16 v[20:23], v[46:47], v[148:149], v[20:23]
  v_mfma_f32_16x16x16_bf16 v[24:27], v[46:47], v[150:151], v[24:27]
  v_and_b32_dpp v40, v14, v12 row_newbcast:3 row_mask:0xf bank_mask:0x5
  v_and_b32_dpp v40, v15, v12 row_newbcast:3 row_mask:0xf bank_mask:0xa
  v_and_b32_dpp v41, v14, v13 row_newbcast:3 row_mask:0xf bank_mask:0x5
  v_and_b32_dpp v41, v15, v13 row_newbcast:3 row_mask:0xf bank_mask:0xa
  s_waitcnt vmcnt(3)
  s_nop 0
  v_mfma_f32_16x16x16_bf16 v[20:23], v[40:41], v[152:153], v[20:23]
  v_mfma_f32_16x16x16_bf16 v[24:27], v[40:41], v[154:155], v[24:27]
  global_load_dwordx3 v[28:30], v35, s[18:19] sc1
  v_and_b32_dpp v42, v14, v12 row_newbcast:11 row_mask:0xf bank_mask:0x5
  v_and_b32_dpp v42, v15, v12 row_newbcast:11 row_mask:0xf bank_mask:0xa
  v_and_b32_dpp v43, v14, v13 row_newbcast:11 row_mask:0xf bank_mask:0x5
  v_and_b32_dpp v43, v15, v13 row_newbcast:11 row_mask:0xf bank_mask:0xa
  s_waitcnt vmcnt(3)
  s_nop 0
  v_mfma_f32_16x16x16_bf16 v[20:23], v[42:43], v[156:157], v[20:23]
  v_mfma_f32_16x16x16_bf16 v[24:27], v[42:43], v[158:159], v[24:27]
  v_and_b32_dpp v44, v14, v12 row_newbcast:7 row_mask:0xf bank_mask:0x5
  v_and_b32_dpp v44, v15, v12 row_newbcast:7 row_mask:0xf bank_mask:0xa
  v_and_b32_dpp v45, v14, v13 row_newbcast:7 row_mask:0xf bank_mask:0x5
  v_and_b32_dpp v45, v15, v13 row_newbcast:7 row_mask:0xf bank_mask:0xa
  s_waitcnt vmcnt(2)
  s_nop 0
  v_mfma_f32_16x16x16_bf16 v[20:23], v[44:45], v[160:161], v[20:23]
  v_mfma_f32_16x16x16_bf16 v[24:27], v[44:45], v[162:163], v[24:27]
  v_and_b32_dpp v46, v14, v12 row_newbcast:15 row_mask:0xf bank_mask:0x5
  v_and_b32_dpp v46, v15, v12 row_newbcast:15 row_mask:0xf bank_mask:0xa
  v_and_b32_dpp v47, v14, v13 row_newbcast:15 row_mask:0xf bank_mask:0x5
  v_and_b32_dpp v47, v15, v13 row_newbcast:15 row_mask:0xf bank_mask:0xa
  s_waitcnt vmcnt(1)
  s_nop 0
  v_mfma_f32_16x16x16_bf16 v[20:23], v[46:47], v[164:165], v[20:23]
  v_mfma_f32_16x16x16_bf16 v[24:27], v[46:47], v[166:167], v[24:27]
  s_branch L_pvdone
L_pv:
  v_and_b32_dpp v40, v14, v12 row_newbcast:0 row_mask:0xf bank_mask:0x5
  v_and_b32_dpp v40, v15, v12 row_newbcast:0 row_mask:0xf bank_mask:0xa
  v_and_b32_dpp v41, v14, v13 row_newbcast:0 row_mask:0xf bank_mask:0x5
  v_and_b32_dpp v41, v15, v13 row_newbcast:0 row_mask:0xf bank_mask:0xa
  s_waitcnt vmcnt(15)
  s_nop 0
  v_mfma_f32_16x16x16_bf16 v[20:23], v[40:41], v[104:105], 0
  v_mfma_f32_16x16x16_bf16 v[24:27], v[40:41], v[106:107], 0
  v_and_b32_dpp v42, v14, v12 row_newbcast:8 row_mask:0xf bank_mask:0x5
  v_and_b32_dpp v42, v15, v12 row_newbcast:8 row_mask:0xf bank_mask:0xa
  v_and_b32_dpp v43, v14, v13 row_newbcast:8 row_mask:0xf bank_mask:0x5
  v_and_b32_dpp v43, v15, v13 row_newbcast:8 row_mask:0xf bank_mask:0xa
  s_waitcnt vmcnt(14)
  s_nop 0
  v_mfma_f32_16x16x16_bf16 v[20:23], v[42:43], v[108:109], v[20:23]
  v_mfma_f32_16x16x16_bf16 v[24:27], v[42:43], v[110:111], v[24:27]
  v_and_b32_dpp v44, v14, v12 row_newbcast:4 row_mask:0xf bank_mask:0x5
  v_and_b32_dpp v44, v15, v12 row_newbcast:4 row_mask:0xf bank_mask:0xa
  v_and_b32_dpp v45, v14, v13 row_newbcast:4 row_mask:0xf bank_mask:0x5
  v_and_b32_dpp v45, v15, v13 row_newbcast:4 row_mask:0xf bank_mask:0xa
  s_waitcnt vmcnt(13)
  s_nop 0
  v_mfma_f32_16x16x16_bf16 v[20:23], v[44:45], v[112:113], v[20:23]
  v_mfma_f32_16x16x16_bf16 v[24:27], v[44:45], v[114:115], v[24:27]
  v_and_b32_dpp v46, v14, v12 row_newbcast:12 row_mask:0xf bank_mask:0x5
  v_and_b32_dpp v46, v15, v12 row_newbcast:12 row_mask:0xf bank_mask:0xa
  v_and_b32_dpp v47, v14, v13 row_newbcast:12 row_mask:0xf bank_mask:0x5
  v_and_b32_dpp v47, v15, v13 row_newbcast:12 row_mask:0xf bank_mask:0xa
  s_waitcnt vmcnt(12)
  s_nop 0
  v_mfma_f32_16x16x16_bf16 v[20:23], v[46:47], v[116:117], v[20:23]
  v_mfma_f32_16x16x16_bf16 v[24:27], v[46:47], v[118:119], v[24:27]
  v_and_b32_dpp v40, v14, v12 row_newbcast:2 row_mask:0xf bank_mask:0x5
  v_and_b32_dpp v40, v15, v12 row_newbcast:2 row_mask:0xf bank_mask:0xa
  v_and_b32_dpp v41, v14, v13 row_newbcast:2 row_mask:0xf bank_mask:0x5
  v_and_b32_dpp v41, v15, v13 row_newbcast:2 row_mask:0xf bank_mask:0xa
  s_waitcnt vmcnt(11)
  s_nop 0
  v_mfma_f32_16x16x16_bf16 v[20:23], v[40:41], v[120:121], v[20:23]
  v_mfma_f32_16x16x16_bf16 v[24:27], v[40:41], v[122:123], v[24:27]
  v_and_b32_dpp v42, v14, v12 row_newbcast:10 row_mask:0xf bank_mask:0x5
  v_and_b32_dpp v42, v15, v12 row_newbcast:10 row_mask:0xf bank_mask:0xa
  v_and_b32_dpp v43, v14, v13 row_newbcast:10 row_mask:0xf bank_mask:0x5
  v_and_b32_dpp v43, v15, v13 row_newbcast:10 row_mask:0xf bank_mask:0xa
  s_waitcnt vmcnt(10)
  s_nop 0
  v_mfma_f32_16x16x16_bf16 v[20:23], v[42:43], v[124:125], v[20:23]
  v_mfma_f32_16x16x16_bf16 v[24:27], v[42:43], v[126:127], v[24:27]
  v_and_b32_dpp v44, v14, v12 row_newbcast:6 row_mask:0xf bank_mask:0x5
  v_and_b32_dpp v44, v15, v12 row_newbcast:6 row_mask:0xf bank_mask:0xa
  v_and_b32_dpp v45, v14, v13 row_newbcast:6 row_mask:0xf bank_mask:0x5
  v_and_b32_dpp v45, v15, v13 row_newbcast:6 row_mask:0xf bank_mask:0xa
  s_waitcnt vmcnt(9)
  s_nop 0
  v_mfma_f32_16x16x16_bf16 v[20:23], v[44:45], v[128:129], v[20:23]
  v_mfma_f32_16x16x16_bf16 v[24:27], v[44:45], v[130:131], v[24:27]
  v_and_b32_dpp v46, v14, v12 row_newbcast:14 row_mask:0xf bank_mask:0x5
  v_and_b32_dpp v46, v15, v12 row_newbcast:14 row_mask:0xf bank_mask:0xa
  v_and_b32_dpp v47, v14, v13 row_newbcast:14 row_mask:0xf bank_mask:0x5
  v_and_b32_dpp v47, v15, v13 row_newbcast:14 row_mask:0xf bank_mask:0xa
  s_waitcnt vmcnt(8)
  s_nop 0
  v_mfma_f32_16x16x16_bf16 v[20:23], v[46:47], v[132:133], v[20:23]
  v_mfma_f32_16x16x16_bf16 v[24:27], v[46:47], v[134:135], v[24:27]
  v_and_b32_dpp v40, v14, v12 row_newbcast:1 row_mask:0xf bank_mask:0x5
  v_and_b32_dpp v40, v15, v12 row_newbcast:1 row_mask:0xf bank_mask:0xa
  v_and_b32_dpp v41, v14, v13 row_newbcast:1 row_mask:0xf bank_mask:0x5
  v_and_b32_dpp v41, v15, v13 row_newbcast:1 row_mask:0xf bank_mask:0xa
  s_waitcnt vmcnt(7)
  s_nop 0
  v_mfma_f32_16x16x16_bf16 v[20:23], v[40:41], v[136:137], v[20:23]
  v_mfma_f32_16x16x16_bf16 v[24:27], v[40:41], v[138:139], v[24:27]
  v_and_b32_dpp v42, v14, v12 row_newbcast:9 row_mask:0xf bank_mask:0x5
  v_and_b32_dpp v42, v15, v12 row_newbcast:9 row_mask:0xf bank_mask:0xa
  v_and_b32_dpp v43, v14, v13 row_newbcast:9 row_mask:0xf bank_mask:0x5
  v_and_b32_dpp v43, v15, v13 row_newbcast:9 row_mask:0xf bank_mask:0xa
  s_waitcnt vmcnt(6)
  s_nop 0
  v_mfma_f32_16x16x16_bf16 v[20:23], v[42:43], v[140:141], v[20:23]
  v_mfma_f32_16x16x16_bf16 v[24:27], v[42:43], v[142:143], v[24:27]
  v_and_b32_dpp v44, v14, v12 row_newbcast:5 row_mask:0xf bank_mask:0x5
  v_and_b32_dpp v44, v15, v12 row_newbcast:5 row_mask:0xf bank_mask:0xa
  v_and_b32_dpp v45, v14, v13 row_newbcast:5 row_mask:0xf bank_mask:0x5
  v_and_b32_dpp v45, v15, v13 row_newbcast:5 row_mask:0xf bank_mask:0xa
  s_waitcnt vmcnt(5)
  s_nop 0
  v_mfma_f32_16x16x16_bf16 v[20:23], v[44:45], v[144:145], v[20:23]
  v_mfma_f32_16x16x16_bf16 v[24:27], v[44:45], v[146:147], v[24:27]
  v_and_b32_dpp v46, v14, v12 row_newbcast:13 row_mask:0xf bank_mask:0x5
  v_and_b32_dpp v46, v15, v12 row_newbcast:13 row_mask:0xf bank_mask:0xa
  v_and_b32_dpp v47, v14, v13 row_newbcast:13 row_mask:0xf bank_mask:0x5
  v_and_b32_dpp v47, v15, v13 row_newbcast:13 row_mask:0xf bank_mask:0xa
  s_waitcnt vmcnt(4)
  s_nop 0
  v_mfma_f32_16x16x16_bf16 v[20:23], v[46:47], v[148:149], v[20:23]
  v_mfma_f32_16x16x16_bf16 v[24:27], v[46:47], v[150:151], v[24:27]
  v_and_b32_dpp v40, v14, v12 row_newbcast:3 row_mask:0xf bank_mask:0x5
  v_and_b32_dpp v40, v15, v12 row_newbcast:3 row_mask:0xf bank_mask:0xa
  v_and_b32_dpp v41, v14, v13 row_newbcast:3 row_mask:0xf bank_mask:0x5
  v_and_b32_dpp v41, v15, v13 row_newbcast:3 row_mask:0xf bank_mask:0xa
  s_waitcnt vmcnt(3)
  s_nop 0
  v_mfma_f32_16x16x16_bf16 v[20:23], v[40:41], v[152:153], v[20:23]
  v_mfma_f32_16x16x16_bf16 v[24:27], v[40:41], v[154:155], v[24:27]
  v_and_b32_dpp v42, v14, v12 row_newbcast:11 row_mask:0xf bank_mask:0x5
  v_and_b32_dpp v42, v15, v12 row_newbcast:11 row_mask:0xf bank_mask:0xa
  v_and_b32_dpp v43, v14, v13 row_newbcast:11 row_mask:0xf bank_mask:0x5
  v_and_b32_dpp v43, v15, v13 row_newbcast:11 row_mask:0xf bank_mask:0xa
  s_waitcnt vmcnt(2)
  s_nop 0
  v_mfma_f32_16x16x16_bf16 v[20:23], v[42:43], v[156:157], v[20:23]
  v_mfma_f32_16x16x16_bf16 v[24:27], v[42:43], v[158:159], v[24:27]
  v_and_b32_dpp v44, v14, v12 row_newbcast:7 row_mask:0xf bank_mask:0x5
  v_and_b32_dpp v44, v15, v12 row_newbcast:7 row_mask:0xf bank_mask:0xa
  v_and_b32_dpp v45, v14, v13 row_newbcast:7 row_mask:0xf bank_mask:0x5
  v_and_b32_dpp v45, v15, v13 row_newbcast:7 row_mask:0xf bank_mask:0xa
  s_waitcnt vmcnt(1)
  s_nop 0
  v_mfma_f32_16x16x16_bf16 v[20:23], v[44:45], v[160:161], v[20:23]
  v_mfma_f32_16x16x16_bf16 v[24:27], v[44:45], v[162:163], v[24:27]
  v_and_b32_dpp v46, v14, v12 row_newbcast:15 row_mask:0xf bank_mask:0x5
  v_and_b32_dpp v46, v15, v12 row_newbcast:15 row_mask:0xf bank_mask:0xa
  v_and_b32_dpp v47, v14, v13 row_newbcast:15 row_mask:0xf bank_mask:0x5
  v_and_b32_dpp v47, v15, v13 row_newbcast:15 row_mask:0xf bank_mask:0xa
  s_waitcnt vmcnt(0)
  s_nop 0
  v_mfma_f32_16x16x16_bf16 v[20:23], v[46:47], v[164:165], v[20:23]
  v_mfma_f32_16x16x16_bf16 v[24:27], v[46:47], v[166:167], v[24:27]
L_pvdone:
  s_nop 7
  v_permlane16_swap_b32 v20, v24
  v_permlane16_swap_b32 v21, v25
  v_permlane16_swap_b32 v22, v26
  v_permlane16_swap_b32 v23, v27
  v_pk_add_f32 v[20:21], v[20:21], v[24:25]
  v_pk_add_f32 v[22:23], v[22:23], v[26:27]
  ds_write_b128 v37, v[20:23] offset:0
  s_waitcnt lgkmcnt(0)
  s_barrier
  s_cmp_gt_u32 s30, 1
  s_cbranch_scc1 L_end
  s_cmp_eq_u32 s30, 1
  s_cbranch_scc1 L_cons
  ds_read_b128 v[44:47], v38 offset:1024
  ds_read_b128 v[48:51], v38 offset:2048
  ds_read_b128 v[52:55], v38 offset:3072
  ds_read_b128 v[56:59], v38 offset:4096
  ds_read_b128 v[60:63], v38 offset:5120
  ds_read_b128 v[64:67], v38 offset:6144
  ds_read_b128 v[68:71], v38 offset:7168
  s_waitcnt lgkmcnt(6)
  v_pk_add_f32 v[20:21], v[20:21], v[44:45]
  v_pk_add_f32 v[22:23], v[22:23], v[46:47]
  s_waitcnt lgkmcnt(5)
  v_pk_add_f32 v[20:21], v[20:21], v[48:49]
  v_pk_add_f32 v[22:23], v[22:23], v[50:51]
  s_waitcnt lgkmcnt(4)
  v_pk_add_f32 v[20:21], v[20:21], v[52:53]
  v_pk_add_f32 v[22:23], v[22:23], v[54:55]
  s_waitcnt lgkmcnt(3)
  v_pk_add_f32 v[20:21], v[20:21], v[56:57]
  v_pk_add_f32 v[22:23], v[22:23], v[58:59]
  s_waitcnt lgkmcnt(2)
  v_pk_add_f32 v[20:21], v[20:21], v[60:61]
  v_pk_add_f32 v[22:23], v[22:23], v[62:63]
  s_waitcnt lgkmcnt(1)
  v_pk_add_f32 v[20:21], v[20:21], v[64:65]
  v_pk_add_f32 v[22:23], v[22:23], v[66:67]
  s_waitcnt lgkmcnt(0)
  v_pk_add_f32 v[20:21], v[20:21], v[68:69]
  v_pk_add_f32 v[22:23], v[22:23], v[70:71]
  v_min_u32 v20, -2, v20
  v_min_u32 v21, -2, v21
  v_min_u32 v22, -2, v22
  v_min_u32 v23, -2, v23
  global_store_dwordx4 v33, v[20:23], s[18:19]
  global_store_dwordx4 v34, v[20:23], s[18:19] sc1
  s_endpgm
L_cons:
  s_mov_b32 s39, 0x400000
  v_cmp_gt_u32 vcc, 16, v18
  s_cbranch_vccz L_cok
L_cchk:
  global_load_dword v18, v36, s[16:17] sc1
  s_sub_u32 s39, s39, 1
  s_cbranch_scc1 L_end
  s_waitcnt vmcnt(0)
  v_cmp_gt_u32 vcc, 16, v18
  s_cbranch_vccnz L_cchk
L_mlpoll:
  global_load_dwordx3 v[28:30], v35, s[18:19] sc1
  s_sub_u32 s39, s39, 1
  s_cbranch_scc1 L_end
L_cok:
  s_waitcnt vmcnt(0)
  v_max3_u32 v7, v28, v29, v30
  v_cmp_eq_u32 vcc, -1, v7
  s_cbranch_vccnz L_mlpoll
  v_cmp_eq_u32 vcc, s38, v30
  v_mov_b32 v19, 524288
  v_mov_b32 v7, v28
  v_cndmask_b32 v30, 0, v19, vcc
  s_nop 1
  v_add_u32_dpp v40, v30, v34 row_newbcast:0 row_mask:0xf bank_mask:0xf
  v_add_u32_dpp v41, v30, v34 row_newbcast:1 row_mask:0xf bank_mask:0xf
  v_add_u32_dpp v42, v30, v34 row_newbcast:2 row_mask:0xf bank_mask:0xf
  v_add_u32_dpp v43, v30, v34 row_newbcast:3 row_mask:0xf bank_mask:0xf
  global_load_dword v44, v40, s[18:19] offset:0 sc1
  global_load_dword v45, v41, s[18:19] offset:1024 sc1
  global_load_dword v46, v42, s[18:19] offset:2048 sc1
  global_load_dword v47, v43, s[18:19] offset:3072 sc1
  s_nop 1
  v_max_f32_dpp v7, v7, v7 row_ror:2 row_mask:0xf bank_mask:0xf
  s_nop 1
  v_max_f32_dpp v7, v7, v7 row_ror:1 row_mask:0xf bank_mask:0xf
  v_mov_b32 v19, v7
  s_nop 1
  v_permlane16_swap_b32 v7, v19
  s_nop 1
  v_max_f32 v7, v7, v19
  v_mov_b32 v19, v7
  s_nop 1
  v_permlane32_swap_b32 v7, v19
  s_nop 1
  v_max_f32 v7, v7, v19
  v_sub_f32 v28, v28, v7
  v_exp_f32 v28, v28
  s_nop 0
  v_mul_f32 v29, v28, v29
  s_nop 1
  v_add_f32_dpp v29, v29, v29 row_ror:2 row_mask:0xf bank_mask:0xf
  s_nop 1
  v_add_f32_dpp v29, v29, v29 row_ror:1 row_mask:0xf bank_mask:0xf
  v_mov_b32 v19, v29
  s_nop 1
  v_permlane16_swap_b32 v29, v19
  s_nop 1
  v_add_f32 v29, v29, v19
  v_mov_b32 v19, v29
  s_nop 1
  v_permlane32_swap_b32 v29, v19
  s_nop 1
  v_add_f32 v29, v29, v19
  v_rcp_f32 v29, v29
  s_lshl_b32 s36, s31, 5
  v_lshlrev_b32 v8, 1, v2
  v_mul_f32 v28, v28, v29
  v_add_u32 v8, s36, v8
  s_branch L_chk
L_poll:
  global_load_dword v44, v40, s[18:19] offset:0 sc1
  global_load_dword v45, v41, s[18:19] offset:1024 sc1
  global_load_dword v46, v42, s[18:19] offset:2048 sc1
  global_load_dword v47, v43, s[18:19] offset:3072 sc1
  s_sub_u32 s39, s39, 1
  s_cbranch_scc1 L_end
L_chk:
  s_waitcnt vmcnt(0)
  v_max3_u32 v7, v44, v45, v46
  v_max_u32 v7, v7, v47
  v_cmp_eq_u32 vcc, -1, v7
  s_cbranch_vccnz L_poll
  v_mul_f32_dpp v20, v28, v44 row_newbcast:0 row_mask:0xf bank_mask:0xf
  v_fmac_f32_dpp v20, v28, v45 row_newbcast:1 row_mask:0xf bank_mask:0xf
  v_fmac_f32_dpp v20, v28, v46 row_newbcast:2 row_mask:0xf bank_mask:0xf
  v_fmac_f32_dpp v20, v28, v47 row_newbcast:3 row_mask:0xf bank_mask:0xf
  v_mov_b32 v21, v20
  s_nop 1
  v_permlane16_swap_b32 v20, v21
  s_nop 1
  v_add_f32 v20, v20, v21
  v_mov_b32 v21, v20
  s_nop 1
  v_permlane32_swap_b32 v20, v21
  s_nop 1
  v_add_f32 v20, v20, v21
  v_cvt_pk_bf16_f32 v20, v20, v20
  s_mov_b64 exec, 0xffff
  global_store_short v8, v20, s[14:15]
L_end:
  s_endpgm
L_codeend:
.section .rodata,"a"
.p2align 6
.amdhsa_kernel standalone__paged_block_table_kv_pagedattention__decode_kernel
  .amdhsa_next_free_vgpr 168
  .amdhsa_next_free_sgpr 48
  .amdhsa_accum_offset 168
  .amdhsa_group_segment_fixed_size 0
  .amdhsa_kernarg_size 64
  .amdhsa_user_sgpr_count 2
  .amdhsa_user_sgpr_kernarg_segment_ptr 1
  .amdhsa_system_sgpr_workgroup_id_x 1
  .amdhsa_float_denorm_mode_32 3
.end_amdhsa_kernel
```
